```python
import torch

def _softmax(x, axis=-1):
    return torch.softmax(x, dim=axis)
def _gelu(x):
    return torch.nn.functional.gelu(x, approximate="tanh")
def _silu(x):
    return torch.nn.functional.silu(x)
def _sigmoid(x):
    return torch.sigmoid(x)
def _layernorm(x, axis=-1, eps=1e-5):
    m = x.mean(dim=axis, keepdim=True)
    v = x.var(dim=axis, keepdim=True, unbiased=False)
    return (x - m) / torch.sqrt(v + eps)
def _scatter_add(tgt, idx, src, axis=0):
    return tgt.clone().index_add_(axis, idx, src)
def _segment_sum(src, seg, n):
    out = torch.zeros((n,) + src.shape[1:], dtype=src.dtype)
    return out.index_add_(0, seg, src)
def _pad(x, pw):
    flat = tuple(v for pair in reversed(pw) for v in pair)
    return torch.nn.functional.pad(x, flat)

kernel_name = 'standalone__sliding_block_cached__decode'

def setup_inputs():

    _w = (lambda a: (lambda t: t.to(torch.bfloat16) if t.is_floating_point() else t)(torch.as_tensor(a)))
    B, Sq, D = 4, 1, 576
    Hq, Hkv, Sk, Dh = 32, 16, 8192, 128
    assert Hq % Hkv == 0, (Hq, Hkv)
    return {
        "x": _w((lambda *s: torch.randn(*s, dtype=torch.bfloat16) * 0.8)(B, Sq, D)),
        "k_cache": _w((lambda *s: torch.randn(*s, dtype=torch.bfloat16) * 0.8)(B, Hkv, Sk, Dh)),
        "v_cache": _w((lambda *s: torch.randn(*s, dtype=torch.bfloat16) * 0.05)(B, Hkv, Sk, Dh)),
        "wq": _w((lambda *s: torch.randn(*s, dtype=torch.bfloat16) * 0.8)(D, Hq * Dh) * (D ** -0.5)),
        "wo": _w((lambda *s: torch.randn(*s, dtype=torch.bfloat16) * 0.05)(Hq * Dh, D) * ((Hq * Dh) ** -0.5)),
    }

def reference(x, k_cache, v_cache, wq, wo):
    B, Sq, D = x.shape
    Hq, Dh = 32, 128
    Hkv, Sk = k_cache.shape[1], k_cache.shape[2]
    W = min(4096, max(256, Sk // 4))
    rep = Hq // Hkv
    q = (lambda x, *d: x.permute(*d))((x @ wq).reshape(B, Sq, Hq, Dh), 0, 2, 1, 3)
    k = (lambda x, n, axis: torch.repeat_interleave(x, n, dim=axis))(k_cache[:, :, Sk - W:, :], rep, axis=1)
    v = (lambda x, n, axis: torch.repeat_interleave(x, n, dim=axis))(v_cache[:, :, Sk - W:, :], rep, axis=1)
    scores = torch.einsum("bhqd,bhkd->bhqk", q, k) * (Dh ** -0.5)
    p = _softmax(scores, axis=-1)
    o = torch.einsum("bhqk,bhkd->bhqd", p, v)
    return (lambda x, *d: x.permute(*d))(o, 0, 2, 1, 3).reshape(B, Sq, Hq * Dh) @ wo
```

```asm
; @launch grid=(256,1,1) block=(1024,1,1) lds=150528
.amdgcn_target "amdgcn-amd-amdhsa--gfx950"
.text
.globl standalone__sliding_block_cached__decode_kernel
.p2align 8
.type standalone__sliding_block_cached__decode_kernel,@function
standalone__sliding_block_cached__decode_kernel:
  s_cmp_ge_u32 s2, 256
  s_cbranch_scc1 L_end
  s_load_dwordx8 s[4:11], s[0:1], 0
  s_load_dwordx4 s[12:15], s[0:1], 32
  s_load_dwordx2 s[16:17], s[0:1], 56
  v_lshrrev_b32 v1, 6, v0
  v_and_b32 v0, 63, v0
  v_readfirstlane_b32 s3, v1
  s_and_b32 s52, s2, 7
  s_lshr_b32 s51, s2, 3
  s_and_b32 s53, s51, 1
  s_lshl_b32 s53, s53, 3
  s_add_u32 s48, s52, s53
  s_lshr_b32 s53, s51, 1
  s_lshr_b32 s49, s53, 2
  s_and_b32 s50, s53, 3
  s_lshl_b32 s61, s49, 4
  s_add_u32 s61, s61, s48
  s_lshl_b32 s59, s61, 21
  s_lshl_b32 s53, s50, 17
  s_add_u32 s59, s59, s53
  s_add_u32 s59, s59, 0x180000
  s_lshl_b32 s60, s48, 2
  s_add_u32 s60, s60, s50
  s_lshl_b32 s56, s3, 1
  s_add_u32 s56, s56, s51
  s_add_u32 s57, s56, 1
  s_and_b32 s56, s56, 31
  s_and_b32 s57, s57, 31
  s_lshl_b32 s56, s56, 12
  s_lshl_b32 s57, s57, 12
  s_cmp_ge_u32 s3, 9
  s_cbranch_scc1 L_noq
  v_lshrrev_b32 v2, 3, v0
  v_and_b32 v5, 7, v0
  v_mul_u32_u24 v3, 147456, v2
  v_lshl_add_u32 v3, v5, 4, v3
  v_mul_u32_u24 v4, 36, v2
  s_lshl_b32 s52, s48, 9
  s_lshl_b32 s53, s50, 7
  s_add_u32 s52, s52, s53
  s_mul_i32 s53, s49, 144
  s_lshl_b32 s54, s3, 1
  s_add_u32 s53, s53, s54
  s_lshl_b32 s54, s53, 13
  s_add_u32 s64, s54, 8192
  s_lshl_b32 s53, s53, 1
  s_waitcnt lgkmcnt(0)
  s_add_u32 s28, s10, s52
  s_addc_u32 s29, s11, 0
  s_and_b32 s29, s29, 0xffff
  s_sub_u32 s30, 4718592, s52
  s_mov_b32 s31, 0x20000
  s_mov_b32 s40, s4
  s_and_b32 s41, s5, 0xffff
  s_mov_b32 s42, 4608
  s_mov_b32 s43, 0x20000
  s_setprio 3
  buffer_load_dwordx4 v[48:51], v3, s[28:31], s54 offen nt
  buffer_load_dwordx4 v[52:55], v3, s[28:31], s64 offen nt
  buffer_load_dword v80, v4, s[40:43], s53 offen offset:0
  buffer_load_dword v81, v4, s[40:43], s53 offen offset:1152
  buffer_load_dword v82, v4, s[40:43], s53 offen offset:2304
  buffer_load_dword v83, v4, s[40:43], s53 offen offset:3456
  s_load_dword s18, s[16:17], 0
  s_branch L_common
L_noq:
  v_lshrrev_b32 v4, 4, v0
  v_and_b32 v5, 15, v0
  v_lshlrev_b32 v6, 2, v4
  v_xor_b32 v5, v5, v6
  v_lshlrev_b32 v5, 4, v5
  v_lshl_add_u32 v4, v4, 8, v5
  v_xor_b32 v5, 16, v4
  v_xor_b32 v6, 32, v4
  v_xor_b32 v7, 48, v4
  s_waitcnt lgkmcnt(0)
  s_add_u32 s20, s6, s59
  s_addc_u32 s21, s7, 0
  s_and_b32 s21, s21, 0xffff
  s_mov_b32 s22, 0x20000
  s_mov_b32 s23, 0x20000
  s_load_dword s18, s[16:17], 0
  s_setprio 2
  s_lshl_b32 s52, s3, 13
  s_mov_b32 m0, s52
  s_add_u32 s52, s52, 4096
  buffer_load_dwordx4 v4, s[20:23], s56 offen offset:0 nt lds
  buffer_load_dwordx4 v5, s[20:23], s56 offen offset:1024 nt lds
  buffer_load_dwordx4 v6, s[20:23], s56 offen offset:2048 nt lds
  buffer_load_dwordx4 v7, s[20:23], s56 offen offset:3072 nt lds
  s_mov_b32 m0, s52
  s_nop 0
  buffer_load_dwordx4 v4, s[20:23], s57 offen offset:0 nt lds
  buffer_load_dwordx4 v5, s[20:23], s57 offen offset:1024 nt lds
  buffer_load_dwordx4 v6, s[20:23], s57 offen offset:2048 nt lds
  buffer_load_dwordx4 v7, s[20:23], s57 offen offset:3072 nt lds
  s_setprio 0
  s_add_u32 s24, s8, s59
  s_addc_u32 s25, s9, 0
  s_and_b32 s25, s25, 0xffff
  s_mov_b32 s26, 0x20000
  s_mov_b32 s27, 0x20000
  s_cmp_lg_u32 s3, 9
  s_cbranch_scc1 L_common2
  v_mov_b32 v80, 0
  v_lshlrev_b32 v4, 2, v0
  v_add_u32 v4, 150016, v4
  s_mov_b64 exec, 0xffff
  ds_write_b32 v4, v80
  s_mov_b64 exec, -1
  s_branch L_common2
L_common:
  s_add_u32 s20, s6, s59
  s_addc_u32 s21, s7, 0
  s_and_b32 s21, s21, 0xffff
  s_mov_b32 s22, 0x20000
  s_mov_b32 s23, 0x20000
  s_add_u32 s24, s8, s59
  s_addc_u32 s25, s9, 0
  s_and_b32 s25, s25, 0xffff
  s_mov_b32 s26, 0x20000
  s_mov_b32 s27, 0x20000
L_common2:
  s_mov_b32 s36, s16
  s_and_b32 s37, s17, 0xffff
  s_mov_b32 s38, 3145728
  s_mov_b32 s39, 0x20000
  s_mul_i32 s52, s60, 73728
  s_add_u32 s32, s12, s52
  s_addc_u32 s33, s13, 0
  s_and_b32 s33, s33, 0xffff
  s_mov_b32 s34, 73728
  s_mov_b32 s35, 0x20000
  s_mov_b32 s44, s14
  s_and_b32 s45, s15, 0xffff
  s_mov_b32 s46, 4608
  s_mov_b32 s47, 0x20000
  s_mov_b32 s62, 0x3fb8aa3b
  s_movk_i32 s63, 0xff
  s_mov_b32 s92, 0xffffff00
  s_getreg_b32 s70, hwreg(HW_REG_XCC_ID, 0, 4)
  v_mov_b32 v2, 0
  v_mov_b32 v3, 0
  v_and_b32 v4, 1, v0
  v_cmp_eq_u32 vcc, 1, v4
  v_mov_b32 v5, 0x0c0c0100
  v_mov_b32 v6, 0x01000c0c
  v_cndmask_b32 v5, v5, v6, vcc
  v_mov_b32 v6, 0x0c0c0302
  v_mov_b32 v7, 0x03020c0c
  v_cndmask_b32 v6, v6, v7, vcc
  v_bfe_u32 v4, v0, 1, 2
  v_mov_b32 v7, 0x0c0c0c0c
  v_cmp_eq_u32 vcc, 0, v4
  s_nop 1
  v_cndmask_b32 v8, v7, v5, vcc
  v_cndmask_b32 v9, v7, v6, vcc
  v_cmp_eq_u32 vcc, 1, v4
  s_nop 1
  v_cndmask_b32 v10, v7, v5, vcc
  v_cndmask_b32 v11, v7, v6, vcc
  v_cmp_eq_u32 vcc, 2, v4
  s_nop 1
  v_cndmask_b32 v12, v7, v5, vcc
  v_cndmask_b32 v13, v7, v6, vcc
  v_cmp_eq_u32 vcc, 3, v4
  s_nop 1
  v_cndmask_b32 v14, v7, v5, vcc
  v_cndmask_b32 v15, v7, v6, vcc
  s_waitcnt lgkmcnt(0)
  s_add_u32 s18, s18, 1
  s_and_b32 s19, s18, 0xff
  v_mov_b32 v1, s19
  s_mov_b32 s68, 0
  s_barrier
  s_cmp_ge_u32 s3, 9
  s_cbranch_scc1 L_noqc
  v_mov_b32 v16, 0
  v_mov_b32 v17, 0
  v_mov_b32 v18, 0
  v_mov_b32 v19, 0
  v_mov_b32 v20, 0
  v_mov_b32 v21, 0
  v_mov_b32 v22, 0
  v_mov_b32 v23, 0
  v_mov_b32 v24, 0
  v_mov_b32 v25, 0
  v_mov_b32 v26, 0
  v_mov_b32 v27, 0
  v_mov_b32 v28, 0
  v_mov_b32 v29, 0
  v_mov_b32 v30, 0
  v_mov_b32 v31, 0
  s_waitcnt vmcnt(0)
  v_perm_b32 v88, v80, v80, v8
  v_perm_b32 v89, v80, v80, v10
  v_perm_b32 v90, v80, v80, v12
  v_perm_b32 v91, v80, v80, v14
  v_perm_b32 v92, v80, v80, v9
  v_perm_b32 v93, v80, v80, v11
  v_perm_b32 v94, v80, v80, v13
  v_perm_b32 v95, v80, v80, v15
  v_mfma_f32_16x16x32_bf16 v[16:19], v[88:91], v[48:51], v[16:19]
  v_perm_b32 v88, v81, v81, v8
  v_perm_b32 v89, v81, v81, v10
  v_perm_b32 v90, v81, v81, v12
  v_perm_b32 v91, v81, v81, v14
  v_mfma_f32_16x16x32_bf16 v[16:19], v[92:95], v[52:55], v[16:19]
  v_perm_b32 v92, v81, v81, v9
  v_perm_b32 v93, v81, v81, v11
  v_perm_b32 v94, v81, v81, v13
  v_perm_b32 v95, v81, v81, v15
  v_mfma_f32_16x16x32_bf16 v[20:23], v[88:91], v[48:51], v[20:23]
  v_perm_b32 v88, v82, v82, v8
  v_perm_b32 v89, v82, v82, v10
  v_perm_b32 v90, v82, v82, v12
  v_perm_b32 v91, v82, v82, v14
  v_mfma_f32_16x16x32_bf16 v[20:23], v[92:95], v[52:55], v[20:23]
  v_perm_b32 v92, v82, v82, v9
  v_perm_b32 v93, v82, v82, v11
  v_perm_b32 v94, v82, v82, v13
  v_perm_b32 v95, v82, v82, v15
  v_mfma_f32_16x16x32_bf16 v[24:27], v[88:91], v[48:51], v[24:27]
  v_perm_b32 v88, v83, v83, v8
  v_perm_b32 v89, v83, v83, v10
  v_perm_b32 v90, v83, v83, v12
  v_perm_b32 v91, v83, v83, v14
  v_mfma_f32_16x16x32_bf16 v[24:27], v[92:95], v[52:55], v[24:27]
  v_perm_b32 v92, v83, v83, v9
  v_perm_b32 v93, v83, v83, v11
  v_perm_b32 v94, v83, v83, v13
  v_perm_b32 v95, v83, v83, v15
  v_mfma_f32_16x16x32_bf16 v[28:31], v[88:91], v[48:51], v[28:31]
  s_nop 1
  v_mfma_f32_16x16x32_bf16 v[28:31], v[92:95], v[52:55], v[28:31]
  v_lshrrev_b32 v4, 5, v0
  v_bfe_u32 v5, v0, 4, 1
  v_lshlrev_b32 v4, 1, v4
  v_add_u32 v4, v4, v5
  v_and_b32 v5, 7, v0
  v_lshl_add_u32 v4, v4, 3, v5
  v_lshlrev_b32 v4, 4, v4
  s_lshl_b32 s52, s3, 11
  s_add_u32 s52, s52, 131072
  v_add_u32 v4, s52, v4
  s_mov_b32 exec_lo, 0x00ff00ff
  s_mov_b32 exec_hi, 0xff00ff00
  s_nop 0
  ds_write_b128 v4, v[16:19] offset:0
  ds_write_b128 v4, v[20:23] offset:512
  ds_write_b128 v4, v[24:27] offset:1024
  ds_write_b128 v4, v[28:31] offset:1536
  s_mov_b64 exec, -1
  v_mov_b32 v5, 150020
  v_mov_b32 v6, 1
  s_mov_b64 exec, 1
  s_waitcnt lgkmcnt(0)
  ds_add_u32 v5, v6
  s_mov_b64 exec, -1
  v_lshrrev_b32 v4, 4, v0
  v_and_b32 v5, 15, v0
  v_lshlrev_b32 v6, 2, v4
  v_xor_b32 v5, v5, v6
  v_lshlrev_b32 v5, 4, v5
  v_lshl_add_u32 v4, v4, 8, v5
  v_xor_b32 v5, 16, v4
  v_xor_b32 v6, 32, v4
  v_xor_b32 v7, 48, v4
  s_setprio 2
  s_lshl_b32 s52, s3, 13
  s_mov_b32 m0, s52
  s_add_u32 s52, s52, 4096
  buffer_load_dwordx4 v4, s[20:23], s56 offen offset:0 nt lds
  buffer_load_dwordx4 v5, s[20:23], s56 offen offset:1024 nt lds
  buffer_load_dwordx4 v6, s[20:23], s56 offen offset:2048 nt lds
  buffer_load_dwordx4 v7, s[20:23], s56 offen offset:3072 nt lds
  s_mov_b32 m0, s52
  s_nop 0
  buffer_load_dwordx4 v4, s[20:23], s57 offen offset:0 nt lds
  buffer_load_dwordx4 v5, s[20:23], s57 offen offset:1024 nt lds
  buffer_load_dwordx4 v6, s[20:23], s57 offen offset:2048 nt lds
  buffer_load_dwordx4 v7, s[20:23], s57 offen offset:3072 nt lds
  s_setprio 0
  s_branch L_kdone
L_noqc:
  s_cmp_lt_u32 s3, 12
  s_cbranch_scc1 L_kdone
  v_mov_b32 v4, 150020
  s_mov_b32 s58, 0
L_spinc:
  ds_read_b32 v5, v4
  s_add_u32 s58, s58, 1
  s_waitcnt lgkmcnt(0)
  v_readfirstlane_b32 s52, v5
  s_cmp_eq_u32 s52, 9
  s_cbranch_scc1 L_spinc_ok
  s_sleep 2
  s_cmp_lt_u32 s58, 160000
  s_cbranch_scc1 L_spinc
L_spinc_ok:
  s_sub_u32 s55, s3, 12
  v_lshrrev_b32 v4, 3, v0
  v_bfe_u32 v5, v0, 2, 1
  v_lshl_add_u32 v4, v5, 3, v4
  v_lshlrev_b32 v4, 4, v4
  v_and_b32 v5, 3, v0
  v_lshl_add_u32 v4, v5, 2, v4
  s_lshl_b32 s52, s55, 9
  s_add_u32 s52, s52, 131072
  v_add_u32 v4, s52, v4
  ds_read_b32 v88, v4 offset:0
  ds_read_b32 v89, v4 offset:256
  ds_read_b32 v90, v4 offset:2048
  ds_read_b32 v91, v4 offset:2304
  ds_read_b32 v92, v4 offset:4096
  ds_read_b32 v93, v4 offset:4352
  ds_read_b32 v94, v4 offset:6144
  ds_read_b32 v95, v4 offset:6400
  ds_read_b32 v96, v4 offset:8192
  ds_read_b32 v97, v4 offset:8448
  ds_read_b32 v98, v4 offset:10240
  ds_read_b32 v99, v4 offset:10496
  ds_read_b32 v100, v4 offset:12288
  ds_read_b32 v101, v4 offset:12544
  s_waitcnt lgkmcnt(4)
  ds_read_b32 v102, v4 offset:14336
  ds_read_b32 v103, v4 offset:14592
  ds_read_b32 v104, v4 offset:16384
  ds_read_b32 v105, v4 offset:16640
  s_lshl_b32 s52, s55, 4
  s_add_u32 s52, s52, s48
  s_lshl_b32 s52, s52, 2
  s_add_u32 s52, s52, s49
  s_lshl_b32 s52, s52, 10
  s_lshl_b32 s53, s50, 8
  s_add_u32 s53, s53, s52
  s_add_u32 s53, s53, 1048576
  v_lshlrev_b32 v4, 2, v0
  s_waitcnt lgkmcnt(0)
  v_add_f32 v88, v88, v89
  v_add_f32 v90, v90, v91
  v_add_f32 v92, v92, v93
  v_add_f32 v94, v94, v95
  v_add_f32 v96, v96, v97
  v_add_f32 v98, v98, v99
  v_add_f32 v100, v100, v101
  v_add_f32 v102, v102, v103
  v_add_f32 v104, v104, v105
  v_add_f32 v88, v88, v90
  v_add_f32 v92, v92, v94
  v_add_f32 v96, v96, v98
  v_add_f32 v100, v100, v102
  v_add_f32 v88, v88, v92
  v_add_f32 v96, v96, v100
  v_add_f32 v88, v88, v96
  v_add_f32 v88, v88, v104
  v_bfi_b32 v6, s63, v1, v88
  s_setprio 3
  buffer_store_dword v6, v4, s[36:39], s53 offen
  s_add_u32 s53, s53, 262144
  buffer_store_dword v6, v4, s[36:39], s53 offen sc1
  s_setprio 0
  s_cmp_lg_u32 s3, 15
  s_cbranch_scc1 L_kdone
  s_lshl_b32 s52, s61, 6
  s_lshl_b32 s53, s50, 2
  s_add_u32 s52, s52, s53
  s_add_u32 s52, s52, 32768
  s_lshl_b32 s53, s70, 8
  s_or_b32 s53, s53, s19
  v_mov_b32 v6, s53
  v_mov_b32 v5, 0
  s_mov_b64 exec, 1
  s_setprio 3
  buffer_store_dword v6, v5, s[36:39], s52 offen sc1
  s_setprio 0
  s_mov_b64 exec, -1
  s_lshl_b32 s65, s61, 6
  s_add_u32 s65, s65, 32768
  v_mov_b32 v3, 0
  s_lshl_b32 s64, s61, 12
  s_add_u32 s64, s64, 1048576
  v_lshlrev_b32 v4, 4, v0
  s_sleep 16
  s_mov_b32 s58, 0
  s_cmp_eq_u32 s58, 6
  s_cselect_b32 s54, 262144, 0
  s_add_u32 s64, s64, s54
  s_setprio 3
  buffer_load_dwordx4 v[48:51], v4, s[36:39], s64 offen offset:0 sc1
  buffer_load_dwordx4 v[52:55], v4, s[36:39], s64 offen offset:1024 sc1
  buffer_load_dwordx4 v[56:59], v4, s[36:39], s64 offen offset:2048 sc1
  buffer_load_dwordx4 v[60:63], v4, s[36:39], s64 offen offset:3072 sc1
  buffer_load_dwordx4 v[64:67], v3, s[36:39], s65 offen sc1
  s_setprio 0
L_poll0:
  s_waitcnt vmcnt(0)
  v_bitop3_b32 v88, v48, v49, v1 bitop3:0x7e
  v_bitop3_b32 v89, v50, v51, v1 bitop3:0x7e
  v_bitop3_b32 v90, v52, v53, v1 bitop3:0x7e
  v_bitop3_b32 v91, v54, v55, v1 bitop3:0x7e
  v_bitop3_b32 v92, v56, v57, v1 bitop3:0x7e
  v_bitop3_b32 v93, v58, v59, v1 bitop3:0x7e
  v_bitop3_b32 v94, v60, v61, v1 bitop3:0x7e
  v_bitop3_b32 v95, v62, v63, v1 bitop3:0x7e
  v_or3_b32 v88, v88, v89, v90
  v_or3_b32 v91, v91, v92, v93
  v_or_b32 v94, v94, v95
  v_or3_b32 v88, v88, v91, v94
  v_and_b32 v88, s63, v88
  v_cmp_ne_u32 vcc, 0, v88
  s_cbranch_vccz L_poll0_got0
  s_sleep 2
  s_cmp_eq_u32 s58, 6
  s_cselect_b32 s54, 262144, 0
  s_add_u32 s64, s64, s54
  s_setprio 3
  buffer_load_dwordx4 v[48:51], v4, s[36:39], s64 offen offset:0 sc1
  buffer_load_dwordx4 v[52:55], v4, s[36:39], s64 offen offset:1024 sc1
  buffer_load_dwordx4 v[56:59], v4, s[36:39], s64 offen offset:2048 sc1
  buffer_load_dwordx4 v[60:63], v4, s[36:39], s64 offen offset:3072 sc1
  buffer_load_dwordx4 v[64:67], v3, s[36:39], s65 offen sc1
  s_setprio 0
  s_add_u32 s58, s58, 1
  s_cmp_lt_u32 s58, 20000
  s_cbranch_scc1 L_poll0
  s_waitcnt vmcnt(0)
L_poll0_got0:
L_poll0_done:
  s_lshl_b32 s54, s70, 8
  s_or_b32 s54, s54, s19
  v_xor_b32 v64, s54, v64
  v_xor_b32 v65, s54, v65
  v_xor_b32 v66, s54, v66
  v_xor_b32 v67, s54, v67
  v_or3_b32 v64, v64, v65, v66
  v_or_b32 v64, v64, v67
  v_and_b32 v64, 0xffff, v64
  v_cmp_eq_u32 vcc, 0, v64
  s_nop 1
  v_cndmask_b32 v6, 0, 1, vcc
  v_mov_b32 v7, 150044
  ds_write_b32 v7, v6
  v_and_b32 v48, s92, v48
  v_and_b32 v49, s92, v49
  v_and_b32 v50, s92, v50
  v_and_b32 v51, s92, v51
  v_and_b32 v52, s92, v52
  v_and_b32 v53, s92, v53
  v_and_b32 v54, s92, v54
  v_and_b32 v55, s92, v55
  v_and_b32 v56, s92, v56
  v_and_b32 v57, s92, v57
  v_and_b32 v58, s92, v58
  v_and_b32 v59, s92, v59
  v_and_b32 v60, s92, v60
  v_and_b32 v61, s92, v61
  v_and_b32 v62, s92, v62
  v_and_b32 v63, s92, v63
  v_add_f32 v48, v48, v52
  v_add_f32 v56, v56, v60
  v_add_f32 v49, v49, v53
  v_add_f32 v57, v57, v61
  v_add_f32 v50, v50, v54
  v_add_f32 v58, v58, v62
  v_add_f32 v51, v51, v55
  v_add_f32 v59, v59, v63
  v_add_f32 v48, v48, v56
  v_add_f32 v49, v49, v57
  v_add_f32 v50, v50, v58
  v_add_f32 v51, v51, v59
  v_cvt_pk_bf16_f32 v88, v48, v49
  v_cvt_pk_bf16_f32 v89, v50, v51
  v_lshlrev_b32 v4, 3, v0
  v_add_u32 v4, 149504, v4
  ds_write_b64 v4, v[88:89]
  v_mov_b32 v5, 1
  v_mov_b32 v4, 150016
  s_waitcnt lgkmcnt(0)
  ds_write_b32 v4, v5
L_kdone:
  v_mov_b32 v4, 150016
  ds_read_b32 v5, v4
  s_waitcnt lgkmcnt(0)
  v_readfirstlane_b32 s52, v5
  s_cmp_eq_u32 s52, 1
  s_cbranch_scc1 L_gotq
  s_mov_b32 s68, 1
  v_lshlrev_b32 v4, 4, v0
  buffer_load_dwordx4 v[16:19], v4, s[24:27], s56 offen offset:0 nt
  buffer_load_dwordx4 v[20:23], v4, s[24:27], s56 offen offset:1024 nt
  buffer_load_dwordx4 v[24:27], v4, s[24:27], s56 offen offset:2048 nt
  buffer_load_dwordx4 v[28:31], v4, s[24:27], s56 offen offset:3072 nt
  buffer_load_dwordx4 v[32:35], v4, s[24:27], s57 offen offset:0 nt
  buffer_load_dwordx4 v[36:39], v4, s[24:27], s57 offen offset:1024 nt
  buffer_load_dwordx4 v[40:43], v4, s[24:27], s57 offen offset:2048 nt
  buffer_load_dwordx4 v[44:47], v4, s[24:27], s57 offen offset:3072 nt
  v_mov_b32 v4, 150016
  s_mov_b32 s58, 0
L_spinq:
  ds_read_b32 v5, v4
  s_add_u32 s58, s58, 1
  s_waitcnt lgkmcnt(0)
  v_readfirstlane_b32 s52, v5
  s_cmp_eq_u32 s52, 1
  s_cbranch_scc1 L_spinq_ok
  s_sleep 2
  s_cmp_lt_u32 s58, 160000
  s_cbranch_scc1 L_spinq
L_spinq_ok:
L_gotq:
  v_bfe_u32 v4, v0, 3, 1
  v_lshrrev_b32 v5, 4, v0
  v_lshlrev_b32 v4, 8, v4
  v_lshl_add_u32 v4, v5, 4, v4
  v_add_u32 v4, 149504, v4
  ds_read_b128 v[88:91], v4 offset:0
  ds_read_b128 v[92:95], v4 offset:64
  ds_read_b128 v[96:99], v4 offset:128
  ds_read_b128 v[100:103], v4 offset:192
  v_and_b32 v6, 15, v0
  v_xor_b32 v5, v5, v6
  v_lshlrev_b32 v5, 4, v5
  v_and_b32 v7, 3, v6
  v_lshlrev_b32 v7, 2, v7
  v_lshrrev_b32 v6, 2, v6
  v_add_u32 v6, v6, v7
  v_lshl_add_u32 v4, v6, 8, v5
  s_lshl_b32 s52, s3, 13
  v_add_u32 v4, s52, v4
  v_xor_b32 v5, 64, v4
  v_xor_b32 v6, 128, v4
  v_xor_b32 v7, 192, v4
  v_mov_b32 v120, 0
  v_mov_b32 v121, 0
  v_mov_b32 v122, 0
  v_mov_b32 v123, 0
  v_mov_b32 v124, 0
  v_mov_b32 v125, 0
  v_mov_b32 v126, 0
  v_mov_b32 v127, 0
  s_cmp_eq_u32 s68, 1
  s_cbranch_scc1 L_kw8
  s_waitcnt vmcnt(0)
  s_branch L_kwd
L_kw8:
  s_waitcnt vmcnt(8)
L_kwd:
  ds_read_b128 v[104:107], v4 offset:0
  ds_read_b128 v[108:111], v5 offset:0
  ds_read_b128 v[112:115], v6 offset:0
  ds_read_b128 v[116:119], v7 offset:0
  s_waitcnt lgkmcnt(3)
  v_mfma_f32_16x16x32_bf16 v[120:123], v[104:107], v[88:91], v[120:123]
  s_waitcnt lgkmcnt(2)
  v_mfma_f32_16x16x32_bf16 v[120:123], v[108:111], v[92:95], v[120:123]
  s_waitcnt lgkmcnt(1)
  v_mfma_f32_16x16x32_bf16 v[120:123], v[112:115], v[96:99], v[120:123]
  s_waitcnt lgkmcnt(0)
  v_mfma_f32_16x16x32_bf16 v[120:123], v[116:119], v[100:103], v[120:123]
  ds_read_b128 v[104:107], v4 offset:4096
  ds_read_b128 v[108:111], v5 offset:4096
  ds_read_b128 v[112:115], v6 offset:4096
  ds_read_b128 v[116:119], v7 offset:4096
  s_waitcnt lgkmcnt(3)
  v_mfma_f32_16x16x32_bf16 v[124:127], v[104:107], v[88:91], v[124:127]
  s_waitcnt lgkmcnt(2)
  v_mfma_f32_16x16x32_bf16 v[124:127], v[108:111], v[92:95], v[124:127]
  s_waitcnt lgkmcnt(1)
  v_mfma_f32_16x16x32_bf16 v[124:127], v[112:115], v[96:99], v[124:127]
  s_waitcnt lgkmcnt(0)
  v_mfma_f32_16x16x32_bf16 v[124:127], v[116:119], v[100:103], v[124:127]
  s_nop 7
  s_mov_b32 s53, 0x3db504f3
  s_mov_b32 s54, 0xffff0000
  v_cvt_pk_bf16_f32 v104, v120, v121
  v_cvt_pk_bf16_f32 v105, v122, v123
  v_cvt_pk_bf16_f32 v106, v124, v125
  v_cvt_pk_bf16_f32 v107, v126, v127
  v_lshlrev_b32 v120, 16, v104
  v_and_b32 v121, s54, v104
  v_lshlrev_b32 v122, 16, v105
  v_and_b32 v123, s54, v105
  v_lshlrev_b32 v124, 16, v106
  v_and_b32 v125, s54, v106
  v_lshlrev_b32 v126, 16, v107
  v_and_b32 v127, s54, v107
  v_mul_f32 v120, s53, v120
  v_mul_f32 v121, s53, v121
  v_mul_f32 v122, s53, v122
  v_mul_f32 v123, s53, v123
  v_mul_f32 v124, s53, v124
  v_mul_f32 v125, s53, v125
  v_mul_f32 v126, s53, v126
  v_mul_f32 v127, s53, v127
  v_cvt_pk_bf16_f32 v104, v120, v121
  v_cvt_pk_bf16_f32 v105, v122, v123
  v_cvt_pk_bf16_f32 v106, v124, v125
  v_cvt_pk_bf16_f32 v107, v126, v127
  v_lshlrev_b32 v120, 16, v104
  v_and_b32 v121, s54, v104
  v_lshlrev_b32 v122, 16, v105
  v_and_b32 v123, s54, v105
  v_lshlrev_b32 v124, 16, v106
  v_and_b32 v125, s54, v106
  v_lshlrev_b32 v126, 16, v107
  v_and_b32 v127, s54, v107
  v_max3_f32 v88, v120, v121, v122
  v_max3_f32 v94, v123, v124, v125
  v_max3_f32 v88, v88, v126, v127
  v_max_f32 v88, v88, v94
  v_mov_b32 v94, v88
  s_nop 1
  v_permlane16_swap_b32 v88, v94
  s_nop 1
  v_max_f32 v88, v88, v94
  v_mov_b32 v94, v88
  s_nop 1
  v_permlane32_swap_b32 v88, v94
  s_nop 1
  v_max_f32 v88, v88, v94
  v_mul_f32 v88, s62, v88
  v_bfe_u32 v4, v0, 3, 1
  v_lshlrev_b32 v4, 2, v4
  s_lshl_b32 s52, s3, 3
  s_add_u32 s52, s52, 150080
  v_add_u32 v4, s52, v4
  s_mov_b32 exec_lo, 0x101
  s_mov_b32 exec_hi, 0
  ds_write_b32 v4, v88
  s_mov_b64 exec, -1
  v_fma_f32 v120, v120, s62, -v88
  v_fma_f32 v121, v121, s62, -v88
  v_fma_f32 v122, v122, s62, -v88
  v_fma_f32 v123, v123, s62, -v88
  v_fma_f32 v124, v124, s62, -v88
  v_fma_f32 v125, v125, s62, -v88
  v_fma_f32 v126, v126, s62, -v88
  v_fma_f32 v127, v127, s62, -v88
  v_exp_f32 v120, v120
  v_exp_f32 v121, v121
  v_exp_f32 v122, v122
  v_exp_f32 v123, v123
  v_exp_f32 v124, v124
  v_exp_f32 v125, v125
  v_exp_f32 v126, v126
  v_exp_f32 v127, v127
  s_nop 0
  v_add_f32 v89, v120, v121
  v_add_f32 v94, v122, v123
  v_add_f32 v95, v124, v125
  v_add_f32 v96, v126, v127
  v_add_f32 v89, v89, v94
  v_add_f32 v95, v95, v96
  v_add_f32 v89, v89, v95
  v_cvt_pk_bf16_f32 v90, v120, v121
  v_cvt_pk_bf16_f32 v91, v122, v123
  v_cvt_pk_bf16_f32 v92, v124, v125
  v_cvt_pk_bf16_f32 v93, v126, v127
  v_mov_b32 v94, v89
  s_nop 1
  v_permlane16_swap_b32 v89, v94
  s_nop 1
  v_add_f32 v89, v89, v94
  v_mov_b32 v94, v89
  s_nop 1
  v_permlane32_swap_b32 v89, v94
  s_nop 1
  v_add_f32 v89, v89, v94
  s_cmp_eq_u32 s68, 1
  s_cbranch_scc1 L_vdone
  v_lshlrev_b32 v4, 4, v0
  buffer_load_dwordx4 v[16:19], v4, s[24:27], s56 offen offset:0 nt
  buffer_load_dwordx4 v[20:23], v4, s[24:27], s56 offen offset:1024 nt
  buffer_load_dwordx4 v[24:27], v4, s[24:27], s56 offen offset:2048 nt
  buffer_load_dwordx4 v[28:31], v4, s[24:27], s56 offen offset:3072 nt
  buffer_load_dwordx4 v[32:35], v4, s[24:27], s57 offen offset:0 nt
  buffer_load_dwordx4 v[36:39], v4, s[24:27], s57 offen offset:1024 nt
  buffer_load_dwordx4 v[40:43], v4, s[24:27], s57 offen offset:2048 nt
  buffer_load_dwordx4 v[44:47], v4, s[24:27], s57 offen offset:3072 nt
L_vdone:
  s_cmp_lt_u32 s3, 4
  s_cbranch_scc0 L_nopv0
  v_mov_b32 v84, 0
  v_mov_b32 v85, 0
  v_mov_b32 v86, 0
  v_mov_b32 v87, 0
  v_perm_b32 v98, v90, v90, v8
  v_perm_b32 v99, v90, v90, v10
  v_perm_b32 v100, v90, v90, v12
  v_perm_b32 v101, v90, v90, v14
  v_perm_b32 v102, v90, v90, v9
  v_perm_b32 v103, v90, v90, v11
  v_perm_b32 v104, v90, v90, v13
  v_perm_b32 v105, v90, v90, v15
  s_waitcnt vmcnt(7)
  v_mfma_f32_16x16x32_bf16 v[84:87], v[98:101], v[16:19], v[84:87]
  v_perm_b32 v98, v91, v91, v8
  v_perm_b32 v99, v91, v91, v10
  v_perm_b32 v100, v91, v91, v12
  v_perm_b32 v101, v91, v91, v14
  s_waitcnt vmcnt(6)
  v_mfma_f32_16x16x32_bf16 v[84:87], v[102:105], v[20:23], v[84:87]
  v_perm_b32 v102, v91, v91, v9
  v_perm_b32 v103, v91, v91, v11
  v_perm_b32 v104, v91, v91, v13
  v_perm_b32 v105, v91, v91, v15
  s_waitcnt vmcnt(5)
  v_mfma_f32_16x16x32_bf16 v[84:87], v[98:101], v[24:27], v[84:87]
  v_perm_b32 v98, v92, v92, v8
  v_perm_b32 v99, v92, v92, v10
  v_perm_b32 v100, v92, v92, v12
  v_perm_b32 v101, v92, v92, v14
  s_waitcnt vmcnt(4)
  v_mfma_f32_16x16x32_bf16 v[84:87], v[102:105], v[28:31], v[84:87]
  v_perm_b32 v102, v92, v92, v9
  v_perm_b32 v103, v92, v92, v11
  v_perm_b32 v104, v92, v92, v13
  v_perm_b32 v105, v92, v92, v15
  s_waitcnt vmcnt(3)
  v_mfma_f32_16x16x32_bf16 v[84:87], v[98:101], v[32:35], v[84:87]
  v_perm_b32 v98, v93, v93, v8
  v_perm_b32 v99, v93, v93, v10
  v_perm_b32 v100, v93, v93, v12
  v_perm_b32 v101, v93, v93, v14
  s_waitcnt vmcnt(2)
  v_mfma_f32_16x16x32_bf16 v[84:87], v[102:105], v[36:39], v[84:87]
  v_perm_b32 v102, v93, v93, v9
  v_perm_b32 v103, v93, v93, v11
  v_perm_b32 v104, v93, v93, v13
  v_perm_b32 v105, v93, v93, v15
  s_waitcnt vmcnt(1)
  v_mfma_f32_16x16x32_bf16 v[84:87], v[98:101], v[40:43], v[84:87]
  s_nop 1
  s_waitcnt vmcnt(0)
  v_mfma_f32_16x16x32_bf16 v[84:87], v[102:105], v[44:47], v[84:87]
  v_lshlrev_b32 v4, 4, v0
  s_lshl_b32 s52, s3, 10
  s_add_u32 s52, s52, 131072
  v_add_u32 v4, s52, v4
  v_lshrrev_b32 v5, 5, v0
  v_lshlrev_b32 v5, 2, v5
  s_lshl_b32 s52, s3, 3
  s_add_u32 s52, s52, 150208
  v_add_u32 v5, s52, v5
  ds_write_b128 v4, v[84:87]
  s_mov_b32 exec_lo, 1
  s_mov_b32 exec_hi, 0x100
  ds_write_b32 v5, v89
  s_mov_b64 exec, -1
L_nopv0:
  s_waitcnt lgkmcnt(0)
  s_barrier
  s_sub_u32 s52, s3, 0
  s_cmp_lt_u32 s52, 4
  s_cbranch_scc0 L_nodma0
  s_sub_u32 s52, s3, 0
  s_lshl_b32 s53, s52, 14
  s_mul_i32 s54, s52, 18432
  s_add_u32 s53, s53, 0
  s_add_u32 s54, s54, 0
  v_lshlrev_b32 v4, 4, v0
  s_mov_b32 m0, s53
  s_add_u32 s53, s53, 1024
  buffer_load_dwordx4 v4, s[32:35], s54 offen nt lds
  s_add_u32 s54, s54, 1152
  v_xor_b32 v6, 32, v4
  s_mov_b32 m0, s53
  s_add_u32 s53, s53, 1024
  buffer_load_dwordx4 v6, s[32:35], s54 offen nt lds
  s_add_u32 s54, s54, 1152
  v_xor_b32 v5, 64, v4
  s_mov_b32 m0, s53
  s_add_u32 s53, s53, 1024
  buffer_load_dwordx4 v5, s[32:35], s54 offen nt lds
  s_add_u32 s54, s54, 1152
  v_xor_b32 v6, 96, v4
  s_mov_b32 m0, s53
  s_add_u32 s53, s53, 1024
  buffer_load_dwordx4 v6, s[32:35], s54 offen nt lds
  s_add_u32 s54, s54, 1152
  s_mov_b32 m0, s53
  s_add_u32 s53, s53, 1024
  buffer_load_dwordx4 v4, s[32:35], s54 offen nt lds
  s_add_u32 s54, s54, 1152
  v_xor_b32 v6, 32, v4
  s_mov_b32 m0, s53
  s_add_u32 s53, s53, 1024
  buffer_load_dwordx4 v6, s[32:35], s54 offen nt lds
  s_add_u32 s54, s54, 1152
  v_xor_b32 v5, 64, v4
  s_mov_b32 m0, s53
  s_add_u32 s53, s53, 1024
  buffer_load_dwordx4 v5, s[32:35], s54 offen nt lds
  s_add_u32 s54, s54, 1152
  v_xor_b32 v6, 96, v4
  s_mov_b32 m0, s53
  s_add_u32 s53, s53, 1024
  buffer_load_dwordx4 v6, s[32:35], s54 offen nt lds
  s_add_u32 s54, s54, 1152
  v_xor_b32 v5, 128, v4
  s_mov_b32 m0, s53
  s_add_u32 s53, s53, 1024
  buffer_load_dwordx4 v5, s[32:35], s54 offen nt lds
  s_add_u32 s54, s54, 1152
  v_xor_b32 v6, 160, v4
  s_mov_b32 m0, s53
  s_add_u32 s53, s53, 1024
  buffer_load_dwordx4 v6, s[32:35], s54 offen nt lds
  s_add_u32 s54, s54, 1152
  v_xor_b32 v5, 192, v4
  s_mov_b32 m0, s53
  s_add_u32 s53, s53, 1024
  buffer_load_dwordx4 v5, s[32:35], s54 offen nt lds
  s_add_u32 s54, s54, 1152
  v_xor_b32 v6, 224, v4
  s_mov_b32 m0, s53
  s_add_u32 s53, s53, 1024
  buffer_load_dwordx4 v6, s[32:35], s54 offen nt lds
  s_add_u32 s54, s54, 1152
  v_xor_b32 v5, 128, v4
  s_mov_b32 m0, s53
  s_add_u32 s53, s53, 1024
  buffer_load_dwordx4 v5, s[32:35], s54 offen nt lds
  s_add_u32 s54, s54, 1152
  v_xor_b32 v6, 160, v4
  s_mov_b32 m0, s53
  s_add_u32 s53, s53, 1024
  buffer_load_dwordx4 v6, s[32:35], s54 offen nt lds
  s_add_u32 s54, s54, 1152
  v_xor_b32 v5, 192, v4
  s_mov_b32 m0, s53
  s_add_u32 s53, s53, 1024
  buffer_load_dwordx4 v5, s[32:35], s54 offen nt lds
  s_add_u32 s54, s54, 1152
  v_xor_b32 v6, 224, v4
  s_mov_b32 m0, s53
  s_add_u32 s53, s53, 1024
  buffer_load_dwordx4 v6, s[32:35], s54 offen nt lds
  s_add_u32 s54, s54, 1152
  v_lshrrev_b32 v5, 3, v0
  v_mul_u32_u24 v5, 1152, v5
  v_and_b32 v6, 7, v0
  v_bfe_u32 v7, v0, 4, 1
  v_lshlrev_b32 v7, 1, v7
  v_xor_b32 v6, v6, v7
  v_lshl_add_u32 v5, v6, 4, v5
  v_add_u32 v5, 1024, v5
  v_xor_b32 v6, 64, v5
  s_lshl_b32 s53, s52, 11
  s_add_u32 s53, s53, 65536
  s_mul_i32 s54, s52, 18432
  s_mov_b32 m0, s53
  s_add_u32 s53, s53, 1024
  buffer_load_dwordx4 v5, s[32:35], s54 offen nt lds
  s_add_u32 s54, s54, 9216
  s_mov_b32 m0, s53
  s_nop 0
  buffer_load_dwordx4 v6, s[32:35], s54 offen nt lds
L_nodma0:
  s_cmp_lt_u32 s3, 4
  s_cbranch_scc1 L_preY
  v_and_b32 v4, 15, v0
  v_lshlrev_b32 v4, 3, v4
  v_lshrrev_b32 v5, 5, v0
  v_lshl_add_u32 v4, v5, 2, v4
  v_add_u32 v4, 150080, v4
  ds_read_b32 v95, v4
  s_lshl_b32 s52, s3, 3
  s_add_u32 s52, s52, 150080
  v_lshlrev_b32 v5, 2, v5
  v_add_u32 v5, s52, v5
  ds_read_b32 v94, v5
  v_add_u32 v96, 128, v5
  s_waitcnt lgkmcnt(0)
  v_max_f32_dpp v95, v95, v95 row_ror:8 row_mask:0xf bank_mask:0xf
  s_nop 1
  v_max_f32_dpp v95, v95, v95 row_ror:4 row_mask:0xf bank_mask:0xf
  s_nop 1
  v_max_f32_dpp v95, v95, v95 row_ror:2 row_mask:0xf bank_mask:0xf
  s_nop 1
  v_max_f32_dpp v95, v95, v95 row_ror:1 row_mask:0xf bank_mask:0xf
  s_nop 0
  v_sub_f32 v94, v94, v95
  v_exp_f32 v94, v94
  s_nop 0
  v_mul_f32 v89, v89, v94
  s_mov_b32 exec_lo, 1
  s_mov_b32 exec_hi, 0x100
  ds_write_b32 v96, v89
  s_mov_b64 exec, -1
  s_cmp_lt_u32 s3, 9
  s_cbranch_scc1 L_preY
  s_cmp_lt_u32 s3, 12
  s_cbranch_scc1 L_preC
  v_mov_b32 v4, 150044
  ds_read_b32 v5, v4
  s_waitcnt lgkmcnt(0)
  v_readfirstlane_b32 s71, v5
  s_sub_u32 s55, s3, 12
  v_lshrrev_b32 v4, 3, v0
  v_bfe_u32 v5, v0, 2, 1
  v_lshl_add_u32 v4, v5, 4, v4
  s_lshr_b32 s52, s55, 1
  s_and_b32 s53, s55, 1
  s_lshl_b32 s69, s52, 5
  s_lshl_b32 s53, s53, 3
  s_add_u32 s53, s53, s69
  v_add_u32 v4, s53, v4
  v_and_b32 v5, 3, v0
  v_lshlrev_b32 v5, 2, v5
  v_lshl_add_u32 v2, v4, 4, v5
  v_add_u32 v2, 131072, v2
  v_and_b32 v6, 15, v0
  v_lshlrev_b32 v6, 3, v6
  s_lshl_b32 s53, s52, 2
  s_add_u32 s53, s53, 150208
  v_add_u32 v124, s53, v6
  v_lshlrev_b32 v125, 3, v0
  v_readlane_b32 s53, v95, s69
  s_nop 2
  v_mov_b32 v126, s53
  v_and_b32 v127, s92, v126
  v_sub_f32 v126, v126, v127
  v_exp_f32 v126, v126
  v_add_u32 v123, -128, v124
  ds_read_b32 v123, v123
  v_and_b32 v6, 15, v0
  v_cmp_gt_u32 vcc, 4, v6
  s_waitcnt lgkmcnt(0)
  v_subrev_f32 v123, s53, v123
  v_exp_f32 v123, v123
  s_nop 0
  v_cndmask_b32 v123, 1.0, v123, vcc
  s_nop 0
  v_readlane_b32 s88, v123, 0
  v_readlane_b32 s89, v123, 1
  v_readlane_b32 s90, v123, 2
  v_readlane_b32 s91, v123, 3
  s_lshl_b32 s52, s61, 13
  s_add_u32 s52, s52, 1572864
  s_lshl_b32 s53, s55, 11
  s_add_u32 s64, s52, s53
  s_lshl_b32 s53, s50, 9
  s_add_u32 s64, s64, s53
  s_lshl_b32 s53, s50, 11
  s_add_u32 s52, s52, s53
  s_add_u32 s53, s50, 1
  s_and_b32 s53, s53, 3
  s_lshl_b32 s53, s53, 9
  s_add_u32 s65, s52, s53
  s_add_u32 s53, s50, 2
  s_and_b32 s53, s53, 3
  s_lshl_b32 s53, s53, 9
  s_add_u32 s66, s52, s53
  s_add_u32 s53, s50, 3
  s_and_b32 s53, s53, 3
  s_lshl_b32 s53, s53, 9
  s_add_u32 s67, s52, s53
  s_branch L_pv
L_preY:
  v_lshrrev_b32 v4, 4, v0
  v_bfe_u32 v5, v0, 2, 2
  v_bfe_u32 v6, v0, 1, 1
  v_and_b32 v7, 1, v0
  s_cmp_eq_u32 s3, 8
  s_cbranch_scc1 L_preYt
  v_and_b32 v2, 1, v4
  v_lshl_add_u32 v2, v2, 2, v5
  v_lshlrev_b32 v2, 1, v2
  s_lshl_b32 s52, s3, 3
  v_add_u32 v6, s52, v6
  v_xor_b32 v6, v6, v2
  v_lshlrev_b32 v6, 4, v6
  v_lshl_add_u32 v6, v7, 3, v6
  v_lshl_add_u32 v5, v4, 3, v5
  v_lshl_add_u32 v120, v5, 10, v6
  s_branch L_preYc
L_preYt:
  v_lshrrev_b32 v2, 1, v5
  v_and_b32 v124, 1, v4
  v_lshl_add_u32 v2, v124, 1, v2
  v_lshlrev_b32 v2, 1, v2
  v_xor_b32 v6, v6, v2
  v_lshlrev_b32 v6, 4, v6
  v_lshl_add_u32 v6, v7, 3, v6
  v_lshl_add_u32 v6, v5, 7, v6
  v_lshl_add_u32 v6, v4, 10, v6
  v_add_u32 v120, 65536, v6
L_preYc:
  v_xor_b32 v121, 32, v120
  v_xor_b32 v122, 64, v120
  v_xor_b32 v123, 96, v120
  v_lshlrev_b32 v124, 4, v4
  v_add_u32 v124, 150336, v124
  v_lshlrev_b32 v4, 12, v4
  v_and_b32 v5, 15, v0
  v_lshl_add_u32 v3, v5, 2, v4
  s_mul_i32 s52, s49, 147456
  s_add_u32 s52, s52, 2097152
  s_lshl_b32 s53, s3, 14
  s_add_u32 s52, s52, s53
  s_lshl_b32 s53, s60, 6
  s_add_u32 s66, s52, s53
  s_branch L_pv
L_preC:
  s_mul_i32 s52, s49, 147456
  s_add_u32 s52, s52, 2097152
  s_lshl_b32 s54, s60, 12
  s_add_u32 s64, s52, s54
  s_mul_i32 s52, s49, 1152
  s_lshl_b32 s54, s60, 5
  s_add_u32 s65, s52, s54
  v_lshlrev_b32 v2, 4, v0
  v_and_b32 v4, 3, v0
  v_lshlrev_b32 v4, 3, v4
  v_lshrrev_b32 v5, 4, v0
  v_lshl_add_u32 v3, v5, 1, v4
L_pv:
  v_lshlrev_b32 v96, 4, v0
  s_lshl_b32 s52, s3, 10
  s_add_u32 s52, s52, 131072
  v_add_u32 v96, s52, v96
  s_cmp_lt_u32 s3, 4
  s_cbranch_scc1 L_disp
  v_mov_b32 v84, 0
  v_mov_b32 v85, 0
  v_mov_b32 v86, 0
  v_mov_b32 v87, 0
  v_perm_b32 v98, v90, v90, v8
  v_perm_b32 v99, v90, v90, v10
  v_perm_b32 v100, v90, v90, v12
  v_perm_b32 v101, v90, v90, v14
  v_perm_b32 v102, v90, v90, v9
  v_perm_b32 v103, v90, v90, v11
  v_perm_b32 v104, v90, v90, v13
  v_perm_b32 v105, v90, v90, v15
  s_waitcnt vmcnt(7)
  v_mfma_f32_16x16x32_bf16 v[84:87], v[98:101], v[16:19], v[84:87]
  v_perm_b32 v98, v91, v91, v8
  v_perm_b32 v99, v91, v91, v10
  v_perm_b32 v100, v91, v91, v12
  v_perm_b32 v101, v91, v91, v14
  s_waitcnt vmcnt(6)
  v_mfma_f32_16x16x32_bf16 v[84:87], v[102:105], v[20:23], v[84:87]
  v_perm_b32 v102, v91, v91, v9
  v_perm_b32 v103, v91, v91, v11
  v_perm_b32 v104, v91, v91, v13
  v_perm_b32 v105, v91, v91, v15
  s_waitcnt vmcnt(5)
  v_mfma_f32_16x16x32_bf16 v[84:87], v[98:101], v[24:27], v[84:87]
  v_perm_b32 v98, v92, v92, v8
  v_perm_b32 v99, v92, v92, v10
  v_perm_b32 v100, v92, v92, v12
  v_perm_b32 v101, v92, v92, v14
  s_waitcnt vmcnt(4)
  v_mfma_f32_16x16x32_bf16 v[84:87], v[102:105], v[28:31], v[84:87]
  v_perm_b32 v102, v92, v92, v9
  v_perm_b32 v103, v92, v92, v11
  v_perm_b32 v104, v92, v92, v13
  v_perm_b32 v105, v92, v92, v15
  s_waitcnt vmcnt(3)
  v_mfma_f32_16x16x32_bf16 v[84:87], v[98:101], v[32:35], v[84:87]
  v_perm_b32 v98, v93, v93, v8
  v_perm_b32 v99, v93, v93, v10
  v_perm_b32 v100, v93, v93, v12
  v_perm_b32 v101, v93, v93, v14
  s_waitcnt vmcnt(2)
  v_mfma_f32_16x16x32_bf16 v[84:87], v[102:105], v[36:39], v[84:87]
  v_perm_b32 v102, v93, v93, v9
  v_perm_b32 v103, v93, v93, v11
  v_perm_b32 v104, v93, v93, v13
  v_perm_b32 v105, v93, v93, v15
  s_waitcnt vmcnt(1)
  v_mfma_f32_16x16x32_bf16 v[84:87], v[98:101], v[40:43], v[84:87]
  s_nop 1
  s_waitcnt vmcnt(0)
  v_mfma_f32_16x16x32_bf16 v[84:87], v[102:105], v[44:47], v[84:87]
L_pvd:
  v_mov_b32 v5, 150024
  v_mov_b32 v6, 1
  s_nop 5
  v_mul_f32 v84, v84, v94
  v_mul_f32 v85, v85, v94
  v_mul_f32 v86, v86, v94
  v_mul_f32 v87, v87, v94
  ds_write_b128 v96, v[84:87]
  s_mov_b64 exec, 1
  s_waitcnt lgkmcnt(0)
  ds_add_u32 v5, v6
  s_mov_b64 exec, -1
L_disp:
  s_cmp_ge_u32 s3, 12
  s_cbranch_scc1 L_D
  s_sub_u32 s52, s3, 0
  s_cmp_lt_u32 s52, 4
  s_cbranch_scc1 L_LD
  s_cmp_lt_u32 s3, 9
  s_cbranch_scc1 L_Y
  s_branch L_postld
L_LD:
  s_waitcnt vmcnt(0)
  v_mov_b32 v5, 150032
  v_mov_b32 v6, 1
  s_mov_b64 exec, 1
  s_waitcnt lgkmcnt(0)
  ds_add_u32 v5, v6
  s_mov_b64 exec, -1
  s_cmp_lt_u32 s3, 9
  s_cbranch_scc1 L_Y
L_postld:
  s_barrier
  s_cmp_lg_u32 s3, 9
  s_cbranch_scc1 L_fin
  s_cmp_ge_u32 s60, 36
  s_cbranch_scc1 L_fin
  s_barrier
  s_sleep 4
  s_mov_b32 s58, 0
  buffer_load_dwordx4 v[16:19], v2, s[36:39], s64 offen offset:0 sc1
  buffer_load_dwordx4 v[20:23], v2, s[36:39], s64 offen offset:1024 sc1
  buffer_load_dwordx4 v[24:27], v2, s[36:39], s64 offen offset:2048 sc1
  buffer_load_dwordx4 v[28:31], v2, s[36:39], s64 offen offset:3072 sc1
L_poll2:
  s_waitcnt vmcnt(0)
  v_bitop3_b32 v88, v16, v17, v1 bitop3:0x7e
  v_bitop3_b32 v89, v18, v19, v1 bitop3:0x7e
  v_bitop3_b32 v90, v20, v21, v1 bitop3:0x7e
  v_bitop3_b32 v91, v22, v23, v1 bitop3:0x7e
  v_bitop3_b32 v92, v24, v25, v1 bitop3:0x7e
  v_bitop3_b32 v93, v26, v27, v1 bitop3:0x7e
  v_bitop3_b32 v94, v28, v29, v1 bitop3:0x7e
  v_bitop3_b32 v95, v30, v31, v1 bitop3:0x7e
  v_or3_b32 v88, v88, v89, v90
  v_or3_b32 v91, v91, v92, v93
  v_or_b32 v94, v94, v95
  v_or3_b32 v88, v88, v91, v94
  v_and_b32 v88, s63, v88
  v_cmp_ne_u32 vcc, 0, v88
  s_cbranch_vccz L_poll2_got0
  buffer_load_dwordx4 v[16:19], v2, s[36:39], s64 offen offset:0 sc1
  buffer_load_dwordx4 v[20:23], v2, s[36:39], s64 offen offset:1024 sc1
  buffer_load_dwordx4 v[24:27], v2, s[36:39], s64 offen offset:2048 sc1
  buffer_load_dwordx4 v[28:31], v2, s[36:39], s64 offen offset:3072 sc1
  s_add_u32 s58, s58, 1
  s_cmp_lt_u32 s58, 20000
  s_cbranch_scc1 L_poll2
  s_waitcnt vmcnt(0)
L_poll2_got0:
L_poll2_done:
  v_and_b32 v16, s92, v16
  v_and_b32 v17, s92, v17
  v_and_b32 v18, s92, v18
  v_and_b32 v19, s92, v19
  v_and_b32 v20, s92, v20
  v_and_b32 v21, s92, v21
  v_and_b32 v22, s92, v22
  v_and_b32 v23, s92, v23
  v_and_b32 v24, s92, v24
  v_and_b32 v25, s92, v25
  v_and_b32 v26, s92, v26
  v_and_b32 v27, s92, v27
  v_and_b32 v28, s92, v28
  v_and_b32 v29, s92, v29
  v_and_b32 v30, s92, v30
  v_and_b32 v31, s92, v31
  v_add_f32 v16, v16, v20
  v_add_f32 v24, v24, v28
  v_add_f32 v17, v17, v21
  v_add_f32 v25, v25, v29
  v_add_f32 v18, v18, v22
  v_add_f32 v26, v26, v30
  v_add_f32 v19, v19, v23
  v_add_f32 v27, v27, v31
  v_add_f32 v16, v16, v24
  v_add_f32 v17, v17, v25
  v_add_f32 v18, v18, v26
  v_add_f32 v19, v19, v27
  s_nop 0
  v_add_f32_dpp v16, v16, v16 row_ror:4 row_mask:0xf bank_mask:0xf
  v_add_f32_dpp v17, v17, v17 row_ror:4 row_mask:0xf bank_mask:0xf
  v_add_f32_dpp v18, v18, v18 row_ror:4 row_mask:0xf bank_mask:0xf
  v_add_f32_dpp v19, v19, v19 row_ror:4 row_mask:0xf bank_mask:0xf
  v_add_f32_dpp v16, v16, v16 row_ror:8 row_mask:0xf bank_mask:0xf
  v_add_f32_dpp v17, v17, v17 row_ror:8 row_mask:0xf bank_mask:0xf
  v_add_f32_dpp v18, v18, v18 row_ror:8 row_mask:0xf bank_mask:0xf
  v_add_f32_dpp v19, v19, v19 row_ror:8 row_mask:0xf bank_mask:0xf
  s_nop 0
  v_permlane32_swap_b32 v16, v18
  v_permlane32_swap_b32 v17, v19
  s_nop 0
  v_add_f32 v16, v16, v18
  v_add_f32 v17, v17, v19
  s_nop 1
  v_permlane16_swap_b32 v16, v17
  s_nop 0
  v_add_f32 v16, v16, v17
  s_mov_b32 exec_lo, 0x000f000f
  s_mov_b32 exec_hi, 0x000f000f
  v_cvt_pk_bf16_f32 v6, v16, v16
  buffer_store_short v6, v3, s[44:47], s65 offen
  s_mov_b32 exec_hi, 0
  s_or_b32 s52, s60, s49
  s_cmp_lg_u32 s52, 0
  s_cbranch_scc1 L_fin0
  s_mov_b32 exec_lo, 1
  v_mov_b32 v5, s18
  v_mov_b32 v4, 0
  buffer_store_dword v5, v4, s[36:39], 0 offen
L_fin0:
  s_mov_b64 exec, -1
  s_branch L_fin
L_D:
  s_setprio 3
  v_mov_b32 v4, 150024
  s_mov_b32 s58, 0
L_spinp:
  ds_read_b32 v5, v4
  s_add_u32 s58, s58, 1
  s_waitcnt lgkmcnt(0)
  v_readfirstlane_b32 s52, v5
  s_cmp_eq_u32 s52, 12
  s_cbranch_scc1 L_spinp_ok
  s_sleep 1
  s_cmp_lt_u32 s58, 160000
  s_cbranch_scc1 L_spinp
L_spinp_ok:
  ds_read_b32 v16, v2 offset:0
  ds_read_b32 v17, v2 offset:1024
  ds_read_b32 v18, v2 offset:2048
  ds_read_b32 v19, v2 offset:3072
  ds_read_b32 v20, v2 offset:4096
  ds_read_b32 v21, v2 offset:5120
  ds_read_b32 v22, v2 offset:6144
  ds_read_b32 v23, v2 offset:7168
  ds_read_b32 v24, v2 offset:8192
  ds_read_b32 v25, v2 offset:9216
  ds_read_b32 v26, v2 offset:10240
  ds_read_b32 v27, v2 offset:11264
  ds_read_b32 v28, v2 offset:12288
  ds_read_b32 v29, v2 offset:13312
  ds_read_b32 v30, v2 offset:14336
  ds_read_b32 v31, v2 offset:15360
  s_waitcnt lgkmcnt(8)
  ds_read_b32 v7, v124
  v_and_b32 v5, 1, v0
  v_cmp_eq_u32 vcc, 1, v5
  s_waitcnt lgkmcnt(0)
  v_mul_f32 v7, v7, v123
  v_mul_f32 v16, s88, v16
  v_mul_f32 v17, s89, v17
  v_mul_f32 v18, s90, v18
  v_mul_f32 v19, s91, v19
  v_add_f32_dpp v7, v7, v7 row_ror:8 row_mask:0xf bank_mask:0xf
  v_add_f32 v16, v16, v17
  v_add_f32 v18, v18, v19
  v_add_f32_dpp v7, v7, v7 row_ror:4 row_mask:0xf bank_mask:0xf
  v_add_f32 v20, v20, v21
  v_add_f32 v22, v22, v23
  v_add_f32_dpp v7, v7, v7 row_ror:2 row_mask:0xf bank_mask:0xf
  v_add_f32 v24, v24, v25
  v_add_f32 v26, v26, v27
  v_add_f32_dpp v7, v7, v7 row_ror:1 row_mask:0xf bank_mask:0xf
  v_add_f32 v28, v28, v29
  v_add_f32 v30, v30, v31
  v_add_f32 v16, v16, v18
  v_add_f32 v20, v20, v22
  v_add_f32 v24, v24, v26
  v_add_f32 v28, v28, v30
  v_add_f32 v16, v16, v20
  v_add_f32 v24, v24, v28
  v_add_f32 v16, v16, v24
  v_mul_f32 v7, v7, v126
  v_mul_f32 v16, v16, v126
  v_cndmask_b32 v6, v127, v7, vcc
  v_bfi_b32 v106, s63, v1, v16
  v_bfi_b32 v107, s63, v1, v6
  s_sub_u32 s55, s3, 12
  s_cmp_eq_u32 s55, s50
  s_cbranch_scc1 L_cons1
  s_cmp_eq_u32 s71, 1
  s_cbranch_scc1 L_pubfast
  buffer_store_dwordx2 v[106:107], v125, s[36:39], s64 offen sc1
  s_branch L_pubdone
L_pubfast:
  buffer_store_dwordx2 v[106:107], v125, s[36:39], s64 offen
L_pubdone:
  s_barrier
  s_branch L_fin
L_cons1:
  s_mov_b32 s58, 0
  buffer_load_dwordx2 v[48:49], v125, s[36:39], s65 offen sc1
  buffer_load_dwordx2 v[50:51], v125, s[36:39], s66 offen sc1
  buffer_load_dwordx2 v[52:53], v125, s[36:39], s67 offen sc1
  s_sleep 4
  buffer_load_dwordx2 v[54:55], v125, s[36:39], s65 offen sc1
  buffer_load_dwordx2 v[56:57], v125, s[36:39], s66 offen sc1
  buffer_load_dwordx2 v[58:59], v125, s[36:39], s67 offen sc1
  s_sleep 4
  buffer_load_dwordx2 v[60:61], v125, s[36:39], s65 offen sc1
  buffer_load_dwordx2 v[62:63], v125, s[36:39], s66 offen sc1
  buffer_load_dwordx2 v[64:65], v125, s[36:39], s67 offen sc1
L_poll1:
  s_waitcnt vmcnt(6)
  v_bitop3_b32 v114, v48, v49, v1 bitop3:0x7e
  v_bitop3_b32 v115, v50, v51, v1 bitop3:0x7e
  v_bitop3_b32 v116, v52, v53, v1 bitop3:0x7e
  v_or3_b32 v114, v114, v115, v116
  v_and_b32 v114, s63, v114
  v_cmp_ne_u32 vcc, 0, v114
  s_cbranch_vccz L_poll1_got0
  buffer_load_dwordx2 v[48:49], v125, s[36:39], s65 offen sc1
  buffer_load_dwordx2 v[50:51], v125, s[36:39], s66 offen sc1
  buffer_load_dwordx2 v[52:53], v125, s[36:39], s67 offen sc1
  s_waitcnt vmcnt(6)
  v_bitop3_b32 v114, v54, v55, v1 bitop3:0x7e
  v_bitop3_b32 v115, v56, v57, v1 bitop3:0x7e
  v_bitop3_b32 v116, v58, v59, v1 bitop3:0x7e
  v_or3_b32 v114, v114, v115, v116
  v_and_b32 v114, s63, v114
  v_cmp_ne_u32 vcc, 0, v114
  s_cbranch_vccz L_poll1_got1
  buffer_load_dwordx2 v[54:55], v125, s[36:39], s65 offen sc1
  buffer_load_dwordx2 v[56:57], v125, s[36:39], s66 offen sc1
  buffer_load_dwordx2 v[58:59], v125, s[36:39], s67 offen sc1
  s_waitcnt vmcnt(6)
  v_bitop3_b32 v114, v60, v61, v1 bitop3:0x7e
  v_bitop3_b32 v115, v62, v63, v1 bitop3:0x7e
  v_bitop3_b32 v116, v64, v65, v1 bitop3:0x7e
  v_or3_b32 v114, v114, v115, v116
  v_and_b32 v114, s63, v114
  v_cmp_ne_u32 vcc, 0, v114
  s_cbranch_vccz L_poll1_got2
  buffer_load_dwordx2 v[60:61], v125, s[36:39], s65 offen sc1
  buffer_load_dwordx2 v[62:63], v125, s[36:39], s66 offen sc1
  buffer_load_dwordx2 v[64:65], v125, s[36:39], s67 offen sc1
  s_add_u32 s58, s58, 1
  s_cmp_lt_u32 s58, 20000
  s_cbranch_scc1 L_poll1
  s_waitcnt vmcnt(0)
L_poll1_got0:
  v_and_b32 v108, s92, v48
  v_and_b32 v109, s92, v49
  v_and_b32 v110, s92, v50
  v_and_b32 v111, s92, v51
  v_and_b32 v112, s92, v52
  v_and_b32 v113, s92, v53
  s_branch L_poll1_done
L_poll1_got1:
  v_and_b32 v108, s92, v54
  v_and_b32 v109, s92, v55
  v_and_b32 v110, s92, v56
  v_and_b32 v111, s92, v57
  v_and_b32 v112, s92, v58
  v_and_b32 v113, s92, v59
  s_branch L_poll1_done
L_poll1_got2:
  v_and_b32 v108, s92, v60
  v_and_b32 v109, s92, v61
  v_and_b32 v110, s92, v62
  v_and_b32 v111, s92, v63
  v_and_b32 v112, s92, v64
  v_and_b32 v113, s92, v65
L_poll1_done:
  v_and_b32 v106, s92, v106
  v_and_b32 v107, s92, v107
  s_nop 1
  v_mov_b32_dpp v114, v107 quad_perm:[0,0,2,2] row_mask:0xf bank_mask:0xf
  v_mov_b32_dpp v118, v107 quad_perm:[1,1,3,3] row_mask:0xf bank_mask:0xf
  v_mov_b32_dpp v115, v109 quad_perm:[0,0,2,2] row_mask:0xf bank_mask:0xf
  v_mov_b32_dpp v119, v109 quad_perm:[1,1,3,3] row_mask:0xf bank_mask:0xf
  v_mov_b32_dpp v116, v111 quad_perm:[0,0,2,2] row_mask:0xf bank_mask:0xf
  v_mov_b32_dpp v120, v111 quad_perm:[1,1,3,3] row_mask:0xf bank_mask:0xf
  v_mov_b32_dpp v117, v113 quad_perm:[0,0,2,2] row_mask:0xf bank_mask:0xf
  v_mov_b32_dpp v121, v113 quad_perm:[1,1,3,3] row_mask:0xf bank_mask:0xf
  v_max3_f32 v5, v114, v115, v116
  v_max_f32 v5, v5, v117
  v_sub_f32 v114, v114, v5
  v_sub_f32 v115, v115, v5
  v_sub_f32 v116, v116, v5
  v_sub_f32 v117, v117, v5
  v_exp_f32 v114, v114
  v_exp_f32 v115, v115
  v_exp_f32 v116, v116
  v_exp_f32 v117, v117
  s_nop 0
  v_mul_f32 v6, v114, v118
  v_mul_f32 v7, v114, v106
  v_fmac_f32 v6, v115, v119
  v_fmac_f32 v7, v115, v108
  v_fmac_f32 v6, v116, v120
  v_fmac_f32 v7, v116, v110
  v_fmac_f32 v6, v117, v121
  v_fmac_f32 v7, v117, v112
  v_rcp_f32 v6, v6
  v_lshlrev_b32 v4, 1, v0
  v_add_u32 v4, 150336, v4
  v_mul_f32 v7, v7, v6
  v_cvt_pk_bf16_f32 v7, v7, v7
  ds_write_b16 v4, v7
  s_waitcnt lgkmcnt(0)
  s_barrier
  s_branch L_fin
L_Y:
  v_mov_b32 v4, 150032
  s_mov_b32 s58, 0
L_spinw:
  ds_read_b32 v5, v4
  s_add_u32 s58, s58, 1
  s_waitcnt lgkmcnt(0)
  v_readfirstlane_b32 s52, v5
  s_cmp_eq_u32 s52, 4
  s_cbranch_scc1 L_spinw_ok
  s_sleep 1
  s_cmp_lt_u32 s58, 160000
  s_cbranch_scc1 L_spinw
L_spinw_ok:
  s_cmp_eq_u32 s3, 8
  s_cbranch_scc1 L_trt
  ds_read_b64_tr_b16 v[48:49], v120 offset:0
  ds_read_b64_tr_b16 v[50:51], v120 offset:4096
  ds_read_b64_tr_b16 v[52:53], v120 offset:32768
  ds_read_b64_tr_b16 v[54:55], v120 offset:36864
  ds_read_b64_tr_b16 v[56:57], v121 offset:0
  ds_read_b64_tr_b16 v[58:59], v121 offset:4096
  ds_read_b64_tr_b16 v[60:61], v121 offset:32768
  ds_read_b64_tr_b16 v[62:63], v121 offset:36864
  ds_read_b64_tr_b16 v[64:65], v122 offset:0
  ds_read_b64_tr_b16 v[66:67], v122 offset:4096
  ds_read_b64_tr_b16 v[68:69], v122 offset:32768
  ds_read_b64_tr_b16 v[70:71], v122 offset:36864
  s_waitcnt lgkmcnt(4)
  ds_read_b64_tr_b16 v[72:73], v123 offset:0
  ds_read_b64_tr_b16 v[74:75], v123 offset:4096
  ds_read_b64_tr_b16 v[76:77], v123 offset:32768
  ds_read_b64_tr_b16 v[78:79], v123 offset:36864
  s_branch L_trd
L_trt:
  ds_read_b64_tr_b16 v[48:49], v120 offset:0
  ds_read_b64_tr_b16 v[50:51], v120 offset:512
  ds_read_b64_tr_b16 v[52:53], v120 offset:4096
  ds_read_b64_tr_b16 v[54:55], v120 offset:4608
  ds_read_b64_tr_b16 v[56:57], v121 offset:0
  ds_read_b64_tr_b16 v[58:59], v121 offset:512
  ds_read_b64_tr_b16 v[60:61], v121 offset:4096
  ds_read_b64_tr_b16 v[62:63], v121 offset:4608
  ds_read_b64_tr_b16 v[64:65], v122 offset:0
  ds_read_b64_tr_b16 v[66:67], v122 offset:512
  ds_read_b64_tr_b16 v[68:69], v122 offset:4096
  ds_read_b64_tr_b16 v[70:71], v122 offset:4608
  s_waitcnt lgkmcnt(4)
  ds_read_b64_tr_b16 v[72:73], v123 offset:0
  ds_read_b64_tr_b16 v[74:75], v123 offset:512
  ds_read_b64_tr_b16 v[76:77], v123 offset:4096
  ds_read_b64_tr_b16 v[78:79], v123 offset:4608
L_trd:
  v_mov_b32 v16, 0
  v_mov_b32 v17, 0
  v_mov_b32 v18, 0
  v_mov_b32 v19, 0
  v_mov_b32 v20, 0
  v_mov_b32 v21, 0
  v_mov_b32 v22, 0
  v_mov_b32 v23, 0
  v_mov_b32 v24, 0
  v_mov_b32 v25, 0
  v_mov_b32 v26, 0
  v_mov_b32 v27, 0
  v_mov_b32 v28, 0
  v_mov_b32 v29, 0
  v_mov_b32 v30, 0
  v_mov_b32 v31, 0
  s_waitcnt lgkmcnt(0)
  s_barrier
  ds_read_b128 v[80:83], v124
  ds_read_b128 v[88:91], v124 offset:64
  s_waitcnt lgkmcnt(1)
  v_mfma_f32_16x16x32_bf16 v[16:19], v[80:83], v[48:51], v[16:19]
  v_mfma_f32_16x16x32_bf16 v[20:23], v[80:83], v[56:59], v[20:23]
  v_mfma_f32_16x16x32_bf16 v[24:27], v[80:83], v[64:67], v[24:27]
  v_mfma_f32_16x16x32_bf16 v[28:31], v[80:83], v[72:75], v[28:31]
  s_waitcnt lgkmcnt(0)
  v_mfma_f32_16x16x32_bf16 v[16:19], v[88:91], v[52:55], v[16:19]
  v_mfma_f32_16x16x32_bf16 v[20:23], v[88:91], v[60:63], v[20:23]
  v_mfma_f32_16x16x32_bf16 v[24:27], v[88:91], v[68:71], v[24:27]
  v_mfma_f32_16x16x32_bf16 v[28:31], v[88:91], v[76:79], v[28:31]
  s_nop 7
  v_mov_b32_dpp v106, v16 quad_perm:[0,1,2,3] row_mask:0x1 bank_mask:0xf
  v_mov_b32_dpp v106, v20 quad_perm:[0,1,2,3] row_mask:0x2 bank_mask:0xf
  v_mov_b32_dpp v106, v24 quad_perm:[0,1,2,3] row_mask:0x4 bank_mask:0xf
  v_mov_b32_dpp v106, v28 quad_perm:[0,1,2,3] row_mask:0x8 bank_mask:0xf
  s_nop 0
  v_bfi_b32 v106, s63, v1, v106
  buffer_store_dword v106, v3, s[36:39], s66 offen sc1
  s_barrier
L_fin:
L_end:
  s_endpgm
.section .rodata,"a"
.p2align 6
.amdhsa_kernel standalone__sliding_block_cached__decode_kernel
  .amdhsa_next_free_vgpr 128
  .amdhsa_next_free_sgpr 96
  .amdhsa_accum_offset 128
  .amdhsa_group_segment_fixed_size 0
  .amdhsa_kernarg_size 64
  .amdhsa_user_sgpr_count 2
  .amdhsa_user_sgpr_kernarg_segment_ptr 1
  .amdhsa_system_sgpr_workgroup_id_x 1
.end_amdhsa_kernel
```
